```python
import torch

def _softmax(x, axis=-1):
    return torch.softmax(x, dim=axis)
def _gelu(x):
    return torch.nn.functional.gelu(x, approximate="tanh")
def _silu(x):
    return torch.nn.functional.silu(x)
def _sigmoid(x):
    return torch.sigmoid(x)
def _layernorm(x, axis=-1, eps=1e-5):
    m = x.mean(dim=axis, keepdim=True)
    v = x.var(dim=axis, keepdim=True, unbiased=False)
    return (x - m) / torch.sqrt(v + eps)
def _scatter_add(tgt, idx, src, axis=0):
    return tgt.clone().index_add_(axis, idx, src)
def _segment_sum(src, seg, n):
    out = torch.zeros((n,) + src.shape[1:], dtype=src.dtype)
    return out.index_add_(0, seg, src)
def _pad(x, pw):
    flat = tuple(v for pair in reversed(pw) for v in pair)
    return torch.nn.functional.pad(x, flat)

kernel_name = 'concat_heads__mha_block_cached__mha_block_cached__decode'

def setup_inputs():

    _w = (lambda a: (lambda t: t.to(torch.bfloat16) if t.is_floating_point() else t)(torch.as_tensor(a)))
    def _A_setup():
        B, Sq, D = 1, 1, 512
        H, Sk, Dh = 32, 16384, 128
        return {
            "x": _w((lambda *s: torch.randn(*s, dtype=torch.bfloat16) * 0.8)(B, Sq, D)),
            "k_cache": _w((lambda *s: torch.randn(*s, dtype=torch.bfloat16) * 1.6)(B, H, Sk, Dh)),
            "v_cache": _w((lambda *s: torch.randn(*s, dtype=torch.bfloat16) * 0.2)(B, H, Sk, Dh)),
            "wq": _w((lambda *s: torch.randn(*s, dtype=torch.bfloat16) * 1.6)(D, H * Dh) * (D ** -0.5)),
            "wo": _w((lambda *s: torch.randn(*s, dtype=torch.bfloat16) * 0.2)(H * Dh, D) * ((H * Dh) ** -0.5)),
        }
    _A_in = _A_setup()

    def _B_setup():
        B, Sq, D = 1, 1, 512
        H, Sk, Dh = 32, 16384, 128
        return {
            "x": _w((lambda *s: torch.randn(*s, dtype=torch.bfloat16) * 0.8)(B, Sq, D)),
            "k_cache": _w((lambda *s: torch.randn(*s, dtype=torch.bfloat16) * 1.6)(B, H, Sk, Dh)),
            "v_cache": _w((lambda *s: torch.randn(*s, dtype=torch.bfloat16) * 0.2)(B, H, Sk, Dh)),
            "wq": _w((lambda *s: torch.randn(*s, dtype=torch.bfloat16) * 1.6)(D, H * Dh) * (D ** -0.5)),
            "wo": _w((lambda *s: torch.randn(*s, dtype=torch.bfloat16) * 0.2)(H * Dh, D) * ((H * Dh) ** -0.5)),
        }
    _B_in = _B_setup()

    return {
        "A_x": _A_in["x"],
        "A_k_cache": _A_in["k_cache"],
        "A_v_cache": _A_in["v_cache"],
        "A_wq": _A_in["wq"],
        "A_wo": _A_in["wo"],
        "B_x": _B_in["x"],
        "B_k_cache": _B_in["k_cache"],
        "B_v_cache": _B_in["v_cache"],
        "B_wq": _B_in["wq"],
        "B_wo": _B_in["wo"],
    }

def reference(A_x, A_k_cache, A_v_cache, A_wq, A_wo, B_x, B_k_cache, B_v_cache, B_wq, B_wo):
    def _A_ref(x, k_cache, v_cache, wq, wo):
        B, Sq, D = x.shape
        H, Dh = 32, 128
        q = (lambda x, *d: x.permute(*d))((x @ wq).reshape(B, Sq, H, Dh), 0, 2, 1, 3)
        scores = torch.einsum("bhqd,bhkd->bhqk", q, k_cache) * (Dh ** -0.5)
        p = _softmax(scores, axis=-1)
        o = torch.einsum("bhqk,bhkd->bhqd", p, v_cache)
        return (lambda x, *d: x.permute(*d))(o, 0, 2, 1, 3).reshape(B, Sq, H * Dh) @ wo

    def _B_ref(x, k_cache, v_cache, wq, wo):
        B, Sq, D = x.shape
        H, Dh = 32, 128
        q = (lambda x, *d: x.permute(*d))((x @ wq).reshape(B, Sq, H, Dh), 0, 2, 1, 3)
        scores = torch.einsum("bhqd,bhkd->bhqk", q, k_cache) * (Dh ** -0.5)
        p = _softmax(scores, axis=-1)
        o = torch.einsum("bhqk,bhkd->bhqd", p, v_cache)
        return (lambda x, *d: x.permute(*d))(o, 0, 2, 1, 3).reshape(B, Sq, H * Dh) @ wo

    a = _A_ref(A_x, A_k_cache, A_v_cache, A_wq, A_wo)
    b = _B_ref(B_x, B_k_cache, B_v_cache, B_wq, B_wo)
    return torch.concatenate([a, b], axis=-1)
```

```asm
; @launch grid=(256,1,1) block=(512,1,1) lds=4352
.amdgcn_target "amdgcn-amd-amdhsa--gfx950"
.text
.globl concat_heads__mha_block_cached__mha_block_cached__decode_kernel
.p2align 8
.type concat_heads__mha_block_cached__mha_block_cached__decode_kernel,@function
concat_heads__mha_block_cached__mha_block_cached__decode_kernel:
    s_cmp_ge_u32 s2, 256
    s_cbranch_scc1 L_end
    s_load_dwordx16 s[16:31], s[0:1], 0
    s_load_dwordx8 s[32:39], s[0:1], 64
    s_load_dwordx2 s[40:41], s[0:1], 96
    s_getpc_b64 s[8:9]
L_pc:
    v_and_b32 v41, 63, v0
    v_lshlrev_b32 v41, 7, v41
    v_lshrrev_b32 v42, 6, v0
    v_lshl_add_u32 v41, v42, 13, v41
    v_cmp_gt_u32 vcc, L_code_end-L_pc, v41
    s_nop 0
    s_and_saveexec_b64 s[6:7], vcc
    s_cbranch_execz L_notouch
    global_load_dword v42, v41, s[8:9]
L_notouch:
    s_mov_b64 exec, s[6:7]
    v_and_b32 v1, 63, v0
    v_lshrrev_b32 v12, 6, v0
    s_and_b32 s68, s2, 31
    s_lshr_b32 s69, s2, 6
    s_bfe_u32 s70, s2, 0x10005
    v_readfirstlane_b32 s71, v12
    s_and_b32 s78, s2, 63
    s_lshl_b32 s78, s78, 2
    s_add_u32 s78, s78, s69
    s_and_b32 s15, s71, 3
    v_lshrrev_b32 v12, 4, v1
    v_and_b32 v13, 15, v1
    s_cmp_ge_u32 s71, 4
    s_cbranch_scc1 L_stream
    s_lshl_b32 s74, s15, 8
    v_lshlrev_b32 v14, 6, v12
    v_add_u32 v14, s74, v14
    v_lshlrev_b32 v40, 18, v12
    v_lshl_add_u32 v40, v13, 4, v40
    s_lshl_b32 s74, s15, 20
    s_lshl_b32 s75, s68, 8
    s_add_u32 s79, s74, s75
    v_lshlrev_b32 v15, 3, v12
    v_lshl_add_u32 v38, v13, 5, v15
    s_lshl_b32 s74, s15, 9
    s_lshl_b32 s75, s78, 11
    s_add_u32 s74, s74, s75
    v_add_u32 v38, s74, v38
    s_waitcnt lgkmcnt(0)
    s_cmp_eq_u32 s70, 0
    s_cselect_b64 s[16:17], s[16:17], s[26:27]
    s_cselect_b64 s[22:23], s[22:23], s[32:33]
    s_cselect_b64 s[24:25], s[24:25], s[34:35]
    s_mov_b32 s60, s16
    s_mov_b32 s61, s17
    s_mov_b32 s62, 0x400
    s_mov_b32 s63, 0x20000
    s_mov_b32 s52, s22
    s_mov_b32 s53, s23
    s_mov_b32 s54, 0x400000
    s_mov_b32 s55, 0x20000
    v_lshl_add_u32 v14, v13, 2, v14
    buffer_load_dword v108, v14, s[60:63], 0 offen
    buffer_load_dwordx4 v[44:47], v40, s[52:55], s79 offen nt
    s_add_u32 s79, s79, 8192
    buffer_load_dwordx4 v[48:51], v40, s[52:55], s79 offen nt
    s_add_u32 s79, s79, 8192
    buffer_load_dwordx4 v[52:55], v40, s[52:55], s79 offen nt
    s_add_u32 s79, s79, 8192
    buffer_load_dwordx4 v[56:59], v40, s[52:55], s79 offen nt
    s_add_u32 s79, s79, 8192
    buffer_load_dwordx4 v[60:63], v40, s[52:55], s79 offen nt
    s_add_u32 s79, s79, 8192
    buffer_load_dwordx4 v[64:67], v40, s[52:55], s79 offen nt
    s_add_u32 s79, s79, 8192
    buffer_load_dwordx4 v[68:71], v40, s[52:55], s79 offen nt
    s_add_u32 s79, s79, 8192
    buffer_load_dwordx4 v[72:75], v40, s[52:55], s79 offen nt
    s_add_u32 s79, s79, 8192
    buffer_load_dwordx4 v[76:79], v40, s[52:55], s79 offen nt
    s_add_u32 s79, s79, 8192
    buffer_load_dwordx4 v[80:83], v40, s[52:55], s79 offen nt
    s_add_u32 s79, s79, 8192
    buffer_load_dwordx4 v[84:87], v40, s[52:55], s79 offen nt
    s_add_u32 s79, s79, 8192
    buffer_load_dwordx4 v[88:91], v40, s[52:55], s79 offen nt
    s_add_u32 s79, s79, 8192
    buffer_load_dwordx4 v[92:95], v40, s[52:55], s79 offen nt
    s_add_u32 s79, s79, 8192
    buffer_load_dwordx4 v[96:99], v40, s[52:55], s79 offen nt
    s_add_u32 s79, s79, 8192
    buffer_load_dwordx4 v[100:103], v40, s[52:55], s79 offen nt
    s_add_u32 s79, s79, 8192
    buffer_load_dwordx4 v[104:107], v40, s[52:55], s79 offen nt
    s_add_u32 s79, s79, 8192
    s_mov_b32 s64, s40
    s_mov_b32 s65, s41
    s_mov_b32 s66, 0x100000
    s_mov_b32 s67, 0x20000
    s_lshl_b32 s75, s78, 3
    s_add_u32 s75, s75, 0x80000
    v_mov_b32 v37, s75
    s_lshl_b32 s74, s68, 17
    s_add_u32 s56, s24, s74
    s_addc_u32 s57, s25, 0
    s_mov_b32 s58, 0x20000
    s_mov_b32 s59, 0x20000
    s_mov_b32 s44, s38
    s_mov_b32 s45, s39
    s_mov_b32 s46, 0x100
    s_mov_b32 s47, 0x20000
    s_mov_b32 s48, s36
    s_mov_b32 s49, s37
    s_mov_b32 s50, 0x800
    s_mov_b32 s51, 0x20000
    s_mov_b32 s12, 0x05040100
    s_mov_b32 s13, 0x07060302
    v_lshlrev_b32 v39, 11, v12
    v_lshl_add_u32 v39, v13, 4, v39
    s_lshl_b32 s74, s15, 8
    v_add_u32 v39, s74, v39
    v_mov_b32 v20, 0
    v_mov_b32 v21, 0
    v_mov_b32 v22, 0
    v_mov_b32 v23, 0
    v_mov_b32 v24, 0
    v_mov_b32 v25, 0
    v_mov_b32 v26, 0
    v_mov_b32 v27, 0
    s_waitcnt vmcnt(16)
    s_waitcnt vmcnt(14)
    v_mov_b32_dpp v109, v108 row_newbcast:0 row_mask:0xf bank_mask:0xf
    v_perm_b32 v12, v48, v44, s12
    v_perm_b32 v13, v48, v44, s13
    v_dot2_f32_bf16 v20, v12, v109, v20
    v_dot2_f32_bf16 v21, v13, v109, v21
    v_perm_b32 v14, v49, v45, s12
    v_perm_b32 v15, v49, v45, s13
    v_dot2_f32_bf16 v22, v14, v109, v22
    v_dot2_f32_bf16 v23, v15, v109, v23
    v_perm_b32 v12, v50, v46, s12
    v_perm_b32 v13, v50, v46, s13
    v_dot2_f32_bf16 v24, v12, v109, v24
    v_dot2_f32_bf16 v25, v13, v109, v25
    v_perm_b32 v14, v51, v47, s12
    v_perm_b32 v15, v51, v47, s13
    v_dot2_f32_bf16 v26, v14, v109, v26
    v_dot2_f32_bf16 v27, v15, v109, v27
    buffer_load_dwordx4 v[44:47], v40, s[52:55], s79 offen nt
    s_add_u32 s79, s79, 8192
    buffer_load_dwordx4 v[48:51], v40, s[52:55], s79 offen nt
    s_add_u32 s79, s79, 8192
    s_waitcnt vmcnt(14)
    v_mov_b32_dpp v110, v108 row_newbcast:1 row_mask:0xf bank_mask:0xf
    v_perm_b32 v12, v56, v52, s12
    v_perm_b32 v13, v56, v52, s13
    v_dot2_f32_bf16 v20, v12, v110, v20
    v_dot2_f32_bf16 v21, v13, v110, v21
    v_perm_b32 v14, v57, v53, s12
    v_perm_b32 v15, v57, v53, s13
    v_dot2_f32_bf16 v22, v14, v110, v22
    v_dot2_f32_bf16 v23, v15, v110, v23
    v_perm_b32 v12, v58, v54, s12
    v_perm_b32 v13, v58, v54, s13
    v_dot2_f32_bf16 v24, v12, v110, v24
    v_dot2_f32_bf16 v25, v13, v110, v25
    v_perm_b32 v14, v59, v55, s12
    v_perm_b32 v15, v59, v55, s13
    v_dot2_f32_bf16 v26, v14, v110, v26
    v_dot2_f32_bf16 v27, v15, v110, v27
    buffer_load_dwordx4 v[52:55], v40, s[52:55], s79 offen nt
    s_add_u32 s79, s79, 8192
    buffer_load_dwordx4 v[56:59], v40, s[52:55], s79 offen nt
    s_add_u32 s79, s79, 8192
    s_waitcnt vmcnt(14)
    v_mov_b32_dpp v109, v108 row_newbcast:2 row_mask:0xf bank_mask:0xf
    v_perm_b32 v12, v64, v60, s12
    v_perm_b32 v13, v64, v60, s13
    v_dot2_f32_bf16 v20, v12, v109, v20
    v_dot2_f32_bf16 v21, v13, v109, v21
    v_perm_b32 v14, v65, v61, s12
    v_perm_b32 v15, v65, v61, s13
    v_dot2_f32_bf16 v22, v14, v109, v22
    v_dot2_f32_bf16 v23, v15, v109, v23
    v_perm_b32 v12, v66, v62, s12
    v_perm_b32 v13, v66, v62, s13
    v_dot2_f32_bf16 v24, v12, v109, v24
    v_dot2_f32_bf16 v25, v13, v109, v25
    v_perm_b32 v14, v67, v63, s12
    v_perm_b32 v15, v67, v63, s13
    v_dot2_f32_bf16 v26, v14, v109, v26
    v_dot2_f32_bf16 v27, v15, v109, v27
    buffer_load_dwordx4 v[60:63], v40, s[52:55], s79 offen nt
    s_add_u32 s79, s79, 8192
    buffer_load_dwordx4 v[64:67], v40, s[52:55], s79 offen nt
    s_add_u32 s79, s79, 8192
    s_waitcnt vmcnt(14)
    v_mov_b32_dpp v110, v108 row_newbcast:3 row_mask:0xf bank_mask:0xf
    v_perm_b32 v12, v72, v68, s12
    v_perm_b32 v13, v72, v68, s13
    v_dot2_f32_bf16 v20, v12, v110, v20
    v_dot2_f32_bf16 v21, v13, v110, v21
    v_perm_b32 v14, v73, v69, s12
    v_perm_b32 v15, v73, v69, s13
    v_dot2_f32_bf16 v22, v14, v110, v22
    v_dot2_f32_bf16 v23, v15, v110, v23
    v_perm_b32 v12, v74, v70, s12
    v_perm_b32 v13, v74, v70, s13
    v_dot2_f32_bf16 v24, v12, v110, v24
    v_dot2_f32_bf16 v25, v13, v110, v25
    v_perm_b32 v14, v75, v71, s12
    v_perm_b32 v15, v75, v71, s13
    v_dot2_f32_bf16 v26, v14, v110, v26
    v_dot2_f32_bf16 v27, v15, v110, v27
    buffer_load_dwordx4 v[68:71], v40, s[52:55], s79 offen nt
    s_add_u32 s79, s79, 8192
    buffer_load_dwordx4 v[72:75], v40, s[52:55], s79 offen nt
    s_add_u32 s79, s79, 8192
    s_waitcnt vmcnt(14)
    v_mov_b32_dpp v109, v108 row_newbcast:4 row_mask:0xf bank_mask:0xf
    v_perm_b32 v12, v80, v76, s12
    v_perm_b32 v13, v80, v76, s13
    v_dot2_f32_bf16 v20, v12, v109, v20
    v_dot2_f32_bf16 v21, v13, v109, v21
    v_perm_b32 v14, v81, v77, s12
    v_perm_b32 v15, v81, v77, s13
    v_dot2_f32_bf16 v22, v14, v109, v22
    v_dot2_f32_bf16 v23, v15, v109, v23
    v_perm_b32 v12, v82, v78, s12
    v_perm_b32 v13, v82, v78, s13
    v_dot2_f32_bf16 v24, v12, v109, v24
    v_dot2_f32_bf16 v25, v13, v109, v25
    v_perm_b32 v14, v83, v79, s12
    v_perm_b32 v15, v83, v79, s13
    v_dot2_f32_bf16 v26, v14, v109, v26
    v_dot2_f32_bf16 v27, v15, v109, v27
    buffer_load_dwordx4 v[76:79], v40, s[52:55], s79 offen nt
    s_add_u32 s79, s79, 8192
    buffer_load_dwordx4 v[80:83], v40, s[52:55], s79 offen nt
    s_add_u32 s79, s79, 8192
    s_waitcnt vmcnt(14)
    v_mov_b32_dpp v110, v108 row_newbcast:5 row_mask:0xf bank_mask:0xf
    v_perm_b32 v12, v88, v84, s12
    v_perm_b32 v13, v88, v84, s13
    v_dot2_f32_bf16 v20, v12, v110, v20
    v_dot2_f32_bf16 v21, v13, v110, v21
    v_perm_b32 v14, v89, v85, s12
    v_perm_b32 v15, v89, v85, s13
    v_dot2_f32_bf16 v22, v14, v110, v22
    v_dot2_f32_bf16 v23, v15, v110, v23
    v_perm_b32 v12, v90, v86, s12
    v_perm_b32 v13, v90, v86, s13
    v_dot2_f32_bf16 v24, v12, v110, v24
    v_dot2_f32_bf16 v25, v13, v110, v25
    v_perm_b32 v14, v91, v87, s12
    v_perm_b32 v15, v91, v87, s13
    v_dot2_f32_bf16 v26, v14, v110, v26
    v_dot2_f32_bf16 v27, v15, v110, v27
    buffer_load_dwordx4 v[84:87], v40, s[52:55], s79 offen nt
    s_add_u32 s79, s79, 8192
    buffer_load_dwordx4 v[88:91], v40, s[52:55], s79 offen nt
    s_add_u32 s79, s79, 8192
    s_waitcnt vmcnt(14)
    v_mov_b32_dpp v109, v108 row_newbcast:6 row_mask:0xf bank_mask:0xf
    v_perm_b32 v12, v96, v92, s12
    v_perm_b32 v13, v96, v92, s13
    v_dot2_f32_bf16 v20, v12, v109, v20
    v_dot2_f32_bf16 v21, v13, v109, v21
    v_perm_b32 v14, v97, v93, s12
    v_perm_b32 v15, v97, v93, s13
    v_dot2_f32_bf16 v22, v14, v109, v22
    v_dot2_f32_bf16 v23, v15, v109, v23
    v_perm_b32 v12, v98, v94, s12
    v_perm_b32 v13, v98, v94, s13
    v_dot2_f32_bf16 v24, v12, v109, v24
    v_dot2_f32_bf16 v25, v13, v109, v25
    v_perm_b32 v14, v99, v95, s12
    v_perm_b32 v15, v99, v95, s13
    v_dot2_f32_bf16 v26, v14, v109, v26
    v_dot2_f32_bf16 v27, v15, v109, v27
    buffer_load_dwordx4 v[92:95], v40, s[52:55], s79 offen nt
    s_add_u32 s79, s79, 8192
    buffer_load_dwordx4 v[96:99], v40, s[52:55], s79 offen nt
    s_add_u32 s79, s79, 8192
    s_waitcnt vmcnt(14)
    v_mov_b32_dpp v110, v108 row_newbcast:7 row_mask:0xf bank_mask:0xf
    v_perm_b32 v12, v104, v100, s12
    v_perm_b32 v13, v104, v100, s13
    v_dot2_f32_bf16 v20, v12, v110, v20
    v_dot2_f32_bf16 v21, v13, v110, v21
    v_perm_b32 v14, v105, v101, s12
    v_perm_b32 v15, v105, v101, s13
    v_dot2_f32_bf16 v22, v14, v110, v22
    v_dot2_f32_bf16 v23, v15, v110, v23
    v_perm_b32 v12, v106, v102, s12
    v_perm_b32 v13, v106, v102, s13
    v_dot2_f32_bf16 v24, v12, v110, v24
    v_dot2_f32_bf16 v25, v13, v110, v25
    v_perm_b32 v14, v107, v103, s12
    v_perm_b32 v15, v107, v103, s13
    v_dot2_f32_bf16 v26, v14, v110, v26
    v_dot2_f32_bf16 v27, v15, v110, v27
    buffer_load_dwordx4 v[100:103], v40, s[52:55], s79 offen nt
    s_add_u32 s79, s79, 8192
    buffer_load_dwordx4 v[104:107], v40, s[52:55], s79 offen nt
    s_barrier
    s_waitcnt vmcnt(14)
    v_mov_b32_dpp v109, v108 row_newbcast:8 row_mask:0xf bank_mask:0xf
    v_perm_b32 v12, v48, v44, s12
    v_perm_b32 v13, v48, v44, s13
    v_dot2_f32_bf16 v20, v12, v109, v20
    v_dot2_f32_bf16 v21, v13, v109, v21
    v_perm_b32 v14, v49, v45, s12
    v_perm_b32 v15, v49, v45, s13
    v_dot2_f32_bf16 v22, v14, v109, v22
    v_dot2_f32_bf16 v23, v15, v109, v23
    v_perm_b32 v12, v50, v46, s12
    v_perm_b32 v13, v50, v46, s13
    v_dot2_f32_bf16 v24, v12, v109, v24
    v_dot2_f32_bf16 v25, v13, v109, v25
    v_perm_b32 v14, v51, v47, s12
    v_perm_b32 v15, v51, v47, s13
    v_dot2_f32_bf16 v26, v14, v109, v26
    v_dot2_f32_bf16 v27, v15, v109, v27
    s_waitcnt vmcnt(12)
    v_mov_b32_dpp v110, v108 row_newbcast:9 row_mask:0xf bank_mask:0xf
    v_perm_b32 v12, v56, v52, s12
    v_perm_b32 v13, v56, v52, s13
    v_dot2_f32_bf16 v20, v12, v110, v20
    v_dot2_f32_bf16 v21, v13, v110, v21
    v_perm_b32 v14, v57, v53, s12
    v_perm_b32 v15, v57, v53, s13
    v_dot2_f32_bf16 v22, v14, v110, v22
    v_dot2_f32_bf16 v23, v15, v110, v23
    v_perm_b32 v12, v58, v54, s12
    v_perm_b32 v13, v58, v54, s13
    v_dot2_f32_bf16 v24, v12, v110, v24
    v_dot2_f32_bf16 v25, v13, v110, v25
    v_perm_b32 v14, v59, v55, s12
    v_perm_b32 v15, v59, v55, s13
    v_dot2_f32_bf16 v26, v14, v110, v26
    v_dot2_f32_bf16 v27, v15, v110, v27
    s_waitcnt vmcnt(10)
    v_mov_b32_dpp v109, v108 row_newbcast:10 row_mask:0xf bank_mask:0xf
    v_perm_b32 v12, v64, v60, s12
    v_perm_b32 v13, v64, v60, s13
    v_dot2_f32_bf16 v20, v12, v109, v20
    v_dot2_f32_bf16 v21, v13, v109, v21
    v_perm_b32 v14, v65, v61, s12
    v_perm_b32 v15, v65, v61, s13
    v_dot2_f32_bf16 v22, v14, v109, v22
    v_dot2_f32_bf16 v23, v15, v109, v23
    v_perm_b32 v12, v66, v62, s12
    v_perm_b32 v13, v66, v62, s13
    v_dot2_f32_bf16 v24, v12, v109, v24
    v_dot2_f32_bf16 v25, v13, v109, v25
    v_perm_b32 v14, v67, v63, s12
    v_perm_b32 v15, v67, v63, s13
    v_dot2_f32_bf16 v26, v14, v109, v26
    v_dot2_f32_bf16 v27, v15, v109, v27
    s_waitcnt vmcnt(8)
    v_mov_b32_dpp v110, v108 row_newbcast:11 row_mask:0xf bank_mask:0xf
    v_perm_b32 v12, v72, v68, s12
    v_perm_b32 v13, v72, v68, s13
    v_dot2_f32_bf16 v20, v12, v110, v20
    v_dot2_f32_bf16 v21, v13, v110, v21
    v_perm_b32 v14, v73, v69, s12
    v_perm_b32 v15, v73, v69, s13
    v_dot2_f32_bf16 v22, v14, v110, v22
    v_dot2_f32_bf16 v23, v15, v110, v23
    v_perm_b32 v12, v74, v70, s12
    v_perm_b32 v13, v74, v70, s13
    v_dot2_f32_bf16 v24, v12, v110, v24
    v_dot2_f32_bf16 v25, v13, v110, v25
    v_perm_b32 v14, v75, v71, s12
    v_perm_b32 v15, v75, v71, s13
    v_dot2_f32_bf16 v26, v14, v110, v26
    v_dot2_f32_bf16 v27, v15, v110, v27
    s_waitcnt vmcnt(6)
    v_mov_b32_dpp v109, v108 row_newbcast:12 row_mask:0xf bank_mask:0xf
    v_perm_b32 v12, v80, v76, s12
    v_perm_b32 v13, v80, v76, s13
    v_dot2_f32_bf16 v20, v12, v109, v20
    v_dot2_f32_bf16 v21, v13, v109, v21
    v_perm_b32 v14, v81, v77, s12
    v_perm_b32 v15, v81, v77, s13
    v_dot2_f32_bf16 v22, v14, v109, v22
    v_dot2_f32_bf16 v23, v15, v109, v23
    v_perm_b32 v12, v82, v78, s12
    v_perm_b32 v13, v82, v78, s13
    v_dot2_f32_bf16 v24, v12, v109, v24
    v_dot2_f32_bf16 v25, v13, v109, v25
    v_perm_b32 v14, v83, v79, s12
    v_perm_b32 v15, v83, v79, s13
    v_dot2_f32_bf16 v26, v14, v109, v26
    v_dot2_f32_bf16 v27, v15, v109, v27
    s_waitcnt vmcnt(4)
    v_mov_b32_dpp v110, v108 row_newbcast:13 row_mask:0xf bank_mask:0xf
    v_perm_b32 v12, v88, v84, s12
    v_perm_b32 v13, v88, v84, s13
    v_dot2_f32_bf16 v20, v12, v110, v20
    v_dot2_f32_bf16 v21, v13, v110, v21
    v_perm_b32 v14, v89, v85, s12
    v_perm_b32 v15, v89, v85, s13
    v_dot2_f32_bf16 v22, v14, v110, v22
    v_dot2_f32_bf16 v23, v15, v110, v23
    v_perm_b32 v12, v90, v86, s12
    v_perm_b32 v13, v90, v86, s13
    v_dot2_f32_bf16 v24, v12, v110, v24
    v_dot2_f32_bf16 v25, v13, v110, v25
    v_perm_b32 v14, v91, v87, s12
    v_perm_b32 v15, v91, v87, s13
    v_dot2_f32_bf16 v26, v14, v110, v26
    v_dot2_f32_bf16 v27, v15, v110, v27
    s_waitcnt vmcnt(2)
    v_mov_b32_dpp v109, v108 row_newbcast:14 row_mask:0xf bank_mask:0xf
    v_perm_b32 v12, v96, v92, s12
    v_perm_b32 v13, v96, v92, s13
    v_dot2_f32_bf16 v20, v12, v109, v20
    v_dot2_f32_bf16 v21, v13, v109, v21
    v_perm_b32 v14, v97, v93, s12
    v_perm_b32 v15, v97, v93, s13
    v_dot2_f32_bf16 v22, v14, v109, v22
    v_dot2_f32_bf16 v23, v15, v109, v23
    v_perm_b32 v12, v98, v94, s12
    v_perm_b32 v13, v98, v94, s13
    v_dot2_f32_bf16 v24, v12, v109, v24
    v_dot2_f32_bf16 v25, v13, v109, v25
    v_perm_b32 v14, v99, v95, s12
    v_perm_b32 v15, v99, v95, s13
    v_dot2_f32_bf16 v26, v14, v109, v26
    v_dot2_f32_bf16 v27, v15, v109, v27
    s_waitcnt vmcnt(0)
    v_mov_b32_dpp v110, v108 row_newbcast:15 row_mask:0xf bank_mask:0xf
    v_perm_b32 v12, v104, v100, s12
    v_perm_b32 v13, v104, v100, s13
    v_dot2_f32_bf16 v20, v12, v110, v20
    v_dot2_f32_bf16 v21, v13, v110, v21
    v_perm_b32 v14, v105, v101, s12
    v_perm_b32 v15, v105, v101, s13
    v_dot2_f32_bf16 v22, v14, v110, v22
    v_dot2_f32_bf16 v23, v15, v110, v23
    v_perm_b32 v12, v106, v102, s12
    v_perm_b32 v13, v106, v102, s13
    v_dot2_f32_bf16 v24, v12, v110, v24
    v_dot2_f32_bf16 v25, v13, v110, v25
    v_perm_b32 v14, v107, v103, s12
    v_perm_b32 v15, v107, v103, s13
    v_dot2_f32_bf16 v26, v14, v110, v26
    v_dot2_f32_bf16 v27, v15, v110, v27
    v_permlane32_swap_b32 v20, v24
    v_permlane32_swap_b32 v21, v25
    v_permlane32_swap_b32 v22, v26
    v_permlane32_swap_b32 v23, v27
    v_add_f32 v20, v20, v24
    v_add_f32 v21, v21, v25
    v_add_f32 v22, v22, v26
    v_add_f32 v23, v23, v27
    s_nop 0
    v_permlane16_swap_b32 v20, v22
    v_permlane16_swap_b32 v21, v23
    v_add_f32 v20, v20, v22
    v_add_f32 v21, v21, v23
    v_lshrrev_b32 v12, 4, v1
    v_and_b32 v13, 15, v1
    v_lshlrev_b32 v12, 3, v12
    v_lshl_add_u32 v12, v13, 5, v12
    s_lshl_b32 s74, s15, 9
    s_add_u32 s74, s74, 0
    v_add_u32 v12, s74, v12
    ds_write_b64 v12, v[20:21]
    s_waitcnt lgkmcnt(0)
    s_barrier
    s_lshl_b32 s76, s70, 7
    s_cmp_lg_u32 s71, 0
    s_cbranch_scc1 L_noz
    v_mov_b32 v12, 0
    v_mov_b32 v13, 0
    v_mov_b32 v14, 0
    v_mov_b32 v15, 0
    v_lshlrev_b32 v16, 5, v1
    s_lshl_b32 s75, s78, 11
    buffer_store_dwordx4 v[12:15], v16, s[64:67], s75 offen sc1
    buffer_store_dwordx4 v[12:15], v16, s[64:67], s75 offen offset:16 sc1
    v_mov_b32 v18, 0
    v_mov_b32 v19, 1
    s_mov_b64 exec, 1
    buffer_store_dwordx2 v[12:13], v37, s[64:67], 0 offen sc1
    s_waitcnt vmcnt(0)
    buffer_atomic_add v19, v18, s[44:47], s76 offen sc1
    s_mov_b64 exec, -1
L_noz:
    s_mov_b32 s72, 0
    buffer_load_dwordx4 v[44:47], v39, s[56:59], s72 offen nt
    buffer_load_dwordx4 v[48:51], v39, s[56:59], s72 offen offset:1024 nt
    s_add_u32 s72, s72, 8192
    buffer_load_dwordx4 v[52:55], v39, s[56:59], s72 offen nt
    buffer_load_dwordx4 v[56:59], v39, s[56:59], s72 offen offset:1024 nt
    s_add_u32 s72, s72, 8192
    s_waitcnt vmcnt(2)
    v_perm_b32 v12, v48, v44, s12
    v_perm_b32 v48, v48, v44, s13
    v_mov_b32 v44, v12
    v_perm_b32 v12, v49, v45, s12
    v_perm_b32 v49, v49, v45, s13
    v_mov_b32 v45, v12
    v_perm_b32 v12, v50, v46, s12
    v_perm_b32 v50, v50, v46, s13
    v_mov_b32 v46, v12
    v_perm_b32 v12, v51, v47, s12
    v_perm_b32 v51, v51, v47, s13
    v_mov_b32 v47, v12
    buffer_load_dwordx4 v[60:63], v39, s[56:59], s72 offen nt
    buffer_load_dwordx4 v[64:67], v39, s[56:59], s72 offen offset:1024 nt
    s_add_u32 s72, s72, 8192
    s_waitcnt vmcnt(2)
    v_perm_b32 v12, v56, v52, s12
    v_perm_b32 v56, v56, v52, s13
    v_mov_b32 v52, v12
    v_perm_b32 v12, v57, v53, s12
    v_perm_b32 v57, v57, v53, s13
    v_mov_b32 v53, v12
    v_perm_b32 v12, v58, v54, s12
    v_perm_b32 v58, v58, v54, s13
    v_mov_b32 v54, v12
    v_perm_b32 v12, v59, v55, s12
    v_perm_b32 v59, v59, v55, s13
    v_mov_b32 v55, v12
    buffer_load_dwordx4 v[68:71], v39, s[56:59], s72 offen nt
    buffer_load_dwordx4 v[72:75], v39, s[56:59], s72 offen offset:1024 nt
    s_add_u32 s72, s72, 8192
    s_waitcnt vmcnt(2)
    v_perm_b32 v12, v64, v60, s12
    v_perm_b32 v64, v64, v60, s13
    v_mov_b32 v60, v12
    v_perm_b32 v12, v65, v61, s12
    v_perm_b32 v65, v65, v61, s13
    v_mov_b32 v61, v12
    v_perm_b32 v12, v66, v62, s12
    v_perm_b32 v66, v66, v62, s13
    v_mov_b32 v62, v12
    v_perm_b32 v12, v67, v63, s12
    v_perm_b32 v67, v67, v63, s13
    v_mov_b32 v63, v12
    buffer_load_dwordx4 v[76:79], v39, s[56:59], s72 offen nt
    buffer_load_dwordx4 v[80:83], v39, s[56:59], s72 offen offset:1024 nt
    s_add_u32 s72, s72, 8192
    s_waitcnt vmcnt(2)
    v_perm_b32 v12, v72, v68, s12
    v_perm_b32 v72, v72, v68, s13
    v_mov_b32 v68, v12
    v_perm_b32 v12, v73, v69, s12
    v_perm_b32 v73, v73, v69, s13
    v_mov_b32 v69, v12
    v_perm_b32 v12, v74, v70, s12
    v_perm_b32 v74, v74, v70, s13
    v_mov_b32 v70, v12
    v_perm_b32 v12, v75, v71, s12
    v_perm_b32 v75, v75, v71, s13
    v_mov_b32 v71, v12
    buffer_load_dwordx4 v[84:87], v39, s[56:59], s72 offen nt
    buffer_load_dwordx4 v[88:91], v39, s[56:59], s72 offen offset:1024 nt
    s_add_u32 s72, s72, 8192
    s_waitcnt vmcnt(2)
    v_perm_b32 v12, v80, v76, s12
    v_perm_b32 v80, v80, v76, s13
    v_mov_b32 v76, v12
    v_perm_b32 v12, v81, v77, s12
    v_perm_b32 v81, v81, v77, s13
    v_mov_b32 v77, v12
    v_perm_b32 v12, v82, v78, s12
    v_perm_b32 v82, v82, v78, s13
    v_mov_b32 v78, v12
    v_perm_b32 v12, v83, v79, s12
    v_perm_b32 v83, v83, v79, s13
    v_mov_b32 v79, v12
    buffer_load_dwordx4 v[92:95], v39, s[56:59], s72 offen nt
    buffer_load_dwordx4 v[96:99], v39, s[56:59], s72 offen offset:1024 nt
    s_add_u32 s72, s72, 8192
    s_waitcnt vmcnt(2)
    v_perm_b32 v12, v88, v84, s12
    v_perm_b32 v88, v88, v84, s13
    v_mov_b32 v84, v12
    v_perm_b32 v12, v89, v85, s12
    v_perm_b32 v89, v89, v85, s13
    v_mov_b32 v85, v12
    v_perm_b32 v12, v90, v86, s12
    v_perm_b32 v90, v90, v86, s13
    v_mov_b32 v86, v12
    v_perm_b32 v12, v91, v87, s12
    v_perm_b32 v91, v91, v87, s13
    v_mov_b32 v87, v12
    buffer_load_dwordx4 v[100:103], v39, s[56:59], s72 offen nt
    buffer_load_dwordx4 v[104:107], v39, s[56:59], s72 offen offset:1024 nt
    s_add_u32 s72, s72, 8192
    s_waitcnt vmcnt(2)
    v_perm_b32 v12, v96, v92, s12
    v_perm_b32 v96, v96, v92, s13
    v_mov_b32 v92, v12
    v_perm_b32 v12, v97, v93, s12
    v_perm_b32 v97, v97, v93, s13
    v_mov_b32 v93, v12
    v_perm_b32 v12, v98, v94, s12
    v_perm_b32 v98, v98, v94, s13
    v_mov_b32 v94, v12
    v_perm_b32 v12, v99, v95, s12
    v_perm_b32 v99, v99, v95, s13
    v_mov_b32 v95, v12
    buffer_load_dwordx4 v[108:111], v39, s[56:59], s72 offen nt
    buffer_load_dwordx4 v[112:115], v39, s[56:59], s72 offen offset:1024 nt
    s_add_u32 s72, s72, 8192
    s_waitcnt vmcnt(2)
    v_perm_b32 v12, v104, v100, s12
    v_perm_b32 v104, v104, v100, s13
    v_mov_b32 v100, v12
    v_perm_b32 v12, v105, v101, s12
    v_perm_b32 v105, v105, v101, s13
    v_mov_b32 v101, v12
    v_perm_b32 v12, v106, v102, s12
    v_perm_b32 v106, v106, v102, s13
    v_mov_b32 v102, v12
    v_perm_b32 v12, v107, v103, s12
    v_perm_b32 v107, v107, v103, s13
    v_mov_b32 v103, v12
    buffer_load_dwordx4 v[116:119], v39, s[56:59], s72 offen nt
    buffer_load_dwordx4 v[120:123], v39, s[56:59], s72 offen offset:1024 nt
    s_add_u32 s72, s72, 8192
    s_waitcnt vmcnt(2)
    v_perm_b32 v12, v112, v108, s12
    v_perm_b32 v112, v112, v108, s13
    v_mov_b32 v108, v12
    v_perm_b32 v12, v113, v109, s12
    v_perm_b32 v113, v113, v109, s13
    v_mov_b32 v109, v12
    v_perm_b32 v12, v114, v110, s12
    v_perm_b32 v114, v114, v110, s13
    v_mov_b32 v110, v12
    v_perm_b32 v12, v115, v111, s12
    v_perm_b32 v115, v115, v111, s13
    v_mov_b32 v111, v12
    buffer_load_dwordx4 v[124:127], v39, s[56:59], s72 offen nt
    buffer_load_dwordx4 v[128:131], v39, s[56:59], s72 offen offset:1024 nt
    s_add_u32 s72, s72, 8192
    s_waitcnt vmcnt(2)
    v_perm_b32 v12, v120, v116, s12
    v_perm_b32 v120, v120, v116, s13
    v_mov_b32 v116, v12
    v_perm_b32 v12, v121, v117, s12
    v_perm_b32 v121, v121, v117, s13
    v_mov_b32 v117, v12
    v_perm_b32 v12, v122, v118, s12
    v_perm_b32 v122, v122, v118, s13
    v_mov_b32 v118, v12
    v_perm_b32 v12, v123, v119, s12
    v_perm_b32 v123, v123, v119, s13
    v_mov_b32 v119, v12
    buffer_load_dwordx4 v[132:135], v39, s[56:59], s72 offen nt
    buffer_load_dwordx4 v[136:139], v39, s[56:59], s72 offen offset:1024 nt
    s_add_u32 s72, s72, 8192
    s_waitcnt vmcnt(2)
    v_perm_b32 v12, v128, v124, s12
    v_perm_b32 v128, v128, v124, s13
    v_mov_b32 v124, v12
    v_perm_b32 v12, v129, v125, s12
    v_perm_b32 v129, v129, v125, s13
    v_mov_b32 v125, v12
    v_perm_b32 v12, v130, v126, s12
    v_perm_b32 v130, v130, v126, s13
    v_mov_b32 v126, v12
    v_perm_b32 v12, v131, v127, s12
    v_perm_b32 v131, v131, v127, s13
    v_mov_b32 v127, v12
    buffer_load_dwordx4 v[140:143], v39, s[56:59], s72 offen nt
    buffer_load_dwordx4 v[144:147], v39, s[56:59], s72 offen offset:1024 nt
    s_add_u32 s72, s72, 8192
    s_waitcnt vmcnt(2)
    v_perm_b32 v12, v136, v132, s12
    v_perm_b32 v136, v136, v132, s13
    v_mov_b32 v132, v12
    v_perm_b32 v12, v137, v133, s12
    v_perm_b32 v137, v137, v133, s13
    v_mov_b32 v133, v12
    v_perm_b32 v12, v138, v134, s12
    v_perm_b32 v138, v138, v134, s13
    v_mov_b32 v134, v12
    v_perm_b32 v12, v139, v135, s12
    v_perm_b32 v139, v139, v135, s13
    v_mov_b32 v135, v12
    buffer_load_dwordx4 v[148:151], v39, s[56:59], s72 offen nt
    buffer_load_dwordx4 v[152:155], v39, s[56:59], s72 offen offset:1024 nt
    s_add_u32 s72, s72, 8192
    s_waitcnt vmcnt(2)
    v_perm_b32 v12, v144, v140, s12
    v_perm_b32 v144, v144, v140, s13
    v_mov_b32 v140, v12
    v_perm_b32 v12, v145, v141, s12
    v_perm_b32 v145, v145, v141, s13
    v_mov_b32 v141, v12
    v_perm_b32 v12, v146, v142, s12
    v_perm_b32 v146, v146, v142, s13
    v_mov_b32 v142, v12
    v_perm_b32 v12, v147, v143, s12
    v_perm_b32 v147, v147, v143, s13
    v_mov_b32 v143, v12
    buffer_load_dwordx4 v[156:159], v39, s[56:59], s72 offen nt
    buffer_load_dwordx4 v[160:163], v39, s[56:59], s72 offen offset:1024 nt
    s_add_u32 s72, s72, 8192
    s_waitcnt vmcnt(2)
    v_perm_b32 v12, v152, v148, s12
    v_perm_b32 v152, v152, v148, s13
    v_mov_b32 v148, v12
    v_perm_b32 v12, v153, v149, s12
    v_perm_b32 v153, v153, v149, s13
    v_mov_b32 v149, v12
    v_perm_b32 v12, v154, v150, s12
    v_perm_b32 v154, v154, v150, s13
    v_mov_b32 v150, v12
    v_perm_b32 v12, v155, v151, s12
    v_perm_b32 v155, v155, v151, s13
    v_mov_b32 v151, v12
    buffer_load_dwordx4 v[164:167], v39, s[56:59], s72 offen nt
    buffer_load_dwordx4 v[168:171], v39, s[56:59], s72 offen offset:1024 nt
    s_add_u32 s72, s72, 8192
    s_waitcnt vmcnt(2)
    v_perm_b32 v12, v160, v156, s12
    v_perm_b32 v160, v160, v156, s13
    v_mov_b32 v156, v12
    v_perm_b32 v12, v161, v157, s12
    v_perm_b32 v161, v161, v157, s13
    v_mov_b32 v157, v12
    v_perm_b32 v12, v162, v158, s12
    v_perm_b32 v162, v162, v158, s13
    v_mov_b32 v158, v12
    v_perm_b32 v12, v163, v159, s12
    v_perm_b32 v163, v163, v159, s13
    v_mov_b32 v159, v12
    s_waitcnt vmcnt(0)
    v_perm_b32 v12, v168, v164, s12
    v_perm_b32 v168, v168, v164, s13
    v_mov_b32 v164, v12
    v_perm_b32 v12, v169, v165, s12
    v_perm_b32 v169, v169, v165, s13
    v_mov_b32 v165, v12
    v_perm_b32 v12, v170, v166, s12
    v_perm_b32 v170, v170, v166, s13
    v_mov_b32 v166, v12
    v_perm_b32 v12, v171, v167, s12
    v_perm_b32 v171, v171, v167, s13
    v_mov_b32 v167, v12
    v_lshlrev_b32 v36, 3, v1
    v_add_u32 v36, 2048, v36
    v_mov_b32 v19, 4096
    v_mov_b32 v18, 0
    v_mov_b32 v41, 0x10000
    v_mov_b32 v20, 0
    v_mov_b32 v21, 0
    v_mov_b32 v22, 0
    v_mov_b32 v23, 0
    v_mov_b32 v24, 0
    v_mov_b32 v25, 0
    v_mov_b32 v26, 0
    v_mov_b32 v27, 0
    s_barrier
    s_cmp_lg_u32 s71, 0
    s_cbranch_scc1 L_notk
    s_mov_b64 exec, 1
    buffer_atomic_add v41, v18, s[44:47], s76 offen sc0 sc1
    s_mov_b64 exec, -1
L_notk:
    ds_read_b64 v[28:29], v36 offset:0
    ds_read_b64 v[30:31], v36 offset:512
    ds_read_b64 v[32:33], v36 offset:1024
    ds_read_b64 v[34:35], v36 offset:1536
    ds_read_b128 v[12:15], v19
    ds_read_b128 v[4:7], v19 offset:16
    s_waitcnt lgkmcnt(0)
    v_max3_f32 v8, v12, v14, v4
    v_max_f32 v8, v8, v6
    v_sub_f32 v12, v12, v8
    v_sub_f32 v14, v14, v8
    v_sub_f32 v4, v4, v8
    v_sub_f32 v6, v6, v8
    v_exp_f32 v12, v12
    v_exp_f32 v14, v14
    v_exp_f32 v4, v4
    v_exp_f32 v6, v6
    v_mul_f32 v9, v12, v13
    v_fmac_f32 v9, v14, v15
    v_fmac_f32 v9, v4, v5
    v_fmac_f32 v9, v6, v7
    v_pk_mul_f32 v[28:29], v[28:29], v[12:13] op_sel_hi:[1,0]
    v_pk_fma_f32 v[28:29], v[30:31], v[14:15], v[28:29] op_sel_hi:[1,0,1]
    v_pk_fma_f32 v[28:29], v[32:33], v[4:5], v[28:29] op_sel_hi:[1,0,1]
    v_pk_fma_f32 v[28:29], v[34:35], v[6:7], v[28:29] op_sel_hi:[1,0,1]
    v_cvt_pk_bf16_f32 v28, v28, v29
.p2align 3
    s_nop 1
    v_mov_b32_dpp v12, v28 row_newbcast:0 row_mask:0xf bank_mask:0xf
    v_dot2_f32_bf16 v20, v44, v12, v20
    v_dot2_f32_bf16 v21, v48, v12, v21
    v_dot2_f32_bf16 v22, v45, v12, v22
    v_dot2_f32_bf16 v23, v49, v12, v23
    v_dot2_f32_bf16 v24, v46, v12, v24
    v_dot2_f32_bf16 v25, v50, v12, v25
    v_dot2_f32_bf16 v26, v47, v12, v26
    v_dot2_f32_bf16 v27, v51, v12, v27
    v_mov_b32_dpp v13, v28 row_newbcast:1 row_mask:0xf bank_mask:0xf
    v_dot2_f32_bf16 v20, v52, v13, v20
    v_dot2_f32_bf16 v21, v56, v13, v21
    v_dot2_f32_bf16 v22, v53, v13, v22
    v_dot2_f32_bf16 v23, v57, v13, v23
    v_dot2_f32_bf16 v24, v54, v13, v24
    v_dot2_f32_bf16 v25, v58, v13, v25
    v_dot2_f32_bf16 v26, v55, v13, v26
    v_dot2_f32_bf16 v27, v59, v13, v27
    v_mov_b32_dpp v12, v28 row_newbcast:2 row_mask:0xf bank_mask:0xf
    v_dot2_f32_bf16 v20, v60, v12, v20
    v_dot2_f32_bf16 v21, v64, v12, v21
    v_dot2_f32_bf16 v22, v61, v12, v22
    v_dot2_f32_bf16 v23, v65, v12, v23
    v_dot2_f32_bf16 v24, v62, v12, v24
    v_dot2_f32_bf16 v25, v66, v12, v25
    v_dot2_f32_bf16 v26, v63, v12, v26
    v_dot2_f32_bf16 v27, v67, v12, v27
    v_mov_b32_dpp v13, v28 row_newbcast:3 row_mask:0xf bank_mask:0xf
    v_dot2_f32_bf16 v20, v68, v13, v20
    v_dot2_f32_bf16 v21, v72, v13, v21
    v_dot2_f32_bf16 v22, v69, v13, v22
    v_dot2_f32_bf16 v23, v73, v13, v23
    v_dot2_f32_bf16 v24, v70, v13, v24
    v_dot2_f32_bf16 v25, v74, v13, v25
    v_dot2_f32_bf16 v26, v71, v13, v26
    v_dot2_f32_bf16 v27, v75, v13, v27
    v_mov_b32_dpp v12, v28 row_newbcast:4 row_mask:0xf bank_mask:0xf
    v_dot2_f32_bf16 v20, v76, v12, v20
    v_dot2_f32_bf16 v21, v80, v12, v21
    v_dot2_f32_bf16 v22, v77, v12, v22
    v_dot2_f32_bf16 v23, v81, v12, v23
    v_dot2_f32_bf16 v24, v78, v12, v24
    v_dot2_f32_bf16 v25, v82, v12, v25
    v_dot2_f32_bf16 v26, v79, v12, v26
    v_dot2_f32_bf16 v27, v83, v12, v27
    v_mov_b32_dpp v13, v28 row_newbcast:5 row_mask:0xf bank_mask:0xf
    v_dot2_f32_bf16 v20, v84, v13, v20
    v_dot2_f32_bf16 v21, v88, v13, v21
    v_dot2_f32_bf16 v22, v85, v13, v22
    v_dot2_f32_bf16 v23, v89, v13, v23
    v_dot2_f32_bf16 v24, v86, v13, v24
    v_dot2_f32_bf16 v25, v90, v13, v25
    v_dot2_f32_bf16 v26, v87, v13, v26
    v_dot2_f32_bf16 v27, v91, v13, v27
    v_mov_b32_dpp v12, v28 row_newbcast:6 row_mask:0xf bank_mask:0xf
    v_dot2_f32_bf16 v20, v92, v12, v20
    v_dot2_f32_bf16 v21, v96, v12, v21
    v_dot2_f32_bf16 v22, v93, v12, v22
    v_dot2_f32_bf16 v23, v97, v12, v23
    v_dot2_f32_bf16 v24, v94, v12, v24
    v_dot2_f32_bf16 v25, v98, v12, v25
    v_dot2_f32_bf16 v26, v95, v12, v26
    v_dot2_f32_bf16 v27, v99, v12, v27
    v_mov_b32_dpp v13, v28 row_newbcast:7 row_mask:0xf bank_mask:0xf
    v_dot2_f32_bf16 v20, v100, v13, v20
    v_dot2_f32_bf16 v21, v104, v13, v21
    v_dot2_f32_bf16 v22, v101, v13, v22
    v_dot2_f32_bf16 v23, v105, v13, v23
    v_dot2_f32_bf16 v24, v102, v13, v24
    v_dot2_f32_bf16 v25, v106, v13, v25
    v_dot2_f32_bf16 v26, v103, v13, v26
    v_dot2_f32_bf16 v27, v107, v13, v27
    v_mov_b32_dpp v12, v28 row_newbcast:8 row_mask:0xf bank_mask:0xf
    v_dot2_f32_bf16 v20, v108, v12, v20
    v_dot2_f32_bf16 v21, v112, v12, v21
    v_dot2_f32_bf16 v22, v109, v12, v22
    v_dot2_f32_bf16 v23, v113, v12, v23
    v_dot2_f32_bf16 v24, v110, v12, v24
    v_dot2_f32_bf16 v25, v114, v12, v25
    v_dot2_f32_bf16 v26, v111, v12, v26
    v_dot2_f32_bf16 v27, v115, v12, v27
    v_mov_b32_dpp v13, v28 row_newbcast:9 row_mask:0xf bank_mask:0xf
    v_dot2_f32_bf16 v20, v116, v13, v20
    v_dot2_f32_bf16 v21, v120, v13, v21
    v_dot2_f32_bf16 v22, v117, v13, v22
    v_dot2_f32_bf16 v23, v121, v13, v23
    v_dot2_f32_bf16 v24, v118, v13, v24
    v_dot2_f32_bf16 v25, v122, v13, v25
    v_dot2_f32_bf16 v26, v119, v13, v26
    v_dot2_f32_bf16 v27, v123, v13, v27
    v_mov_b32_dpp v12, v28 row_newbcast:10 row_mask:0xf bank_mask:0xf
    v_dot2_f32_bf16 v20, v124, v12, v20
    v_dot2_f32_bf16 v21, v128, v12, v21
    v_dot2_f32_bf16 v22, v125, v12, v22
    v_dot2_f32_bf16 v23, v129, v12, v23
    v_dot2_f32_bf16 v24, v126, v12, v24
    v_dot2_f32_bf16 v25, v130, v12, v25
    v_dot2_f32_bf16 v26, v127, v12, v26
    v_dot2_f32_bf16 v27, v131, v12, v27
    v_mov_b32_dpp v13, v28 row_newbcast:11 row_mask:0xf bank_mask:0xf
    v_dot2_f32_bf16 v20, v132, v13, v20
    v_dot2_f32_bf16 v21, v136, v13, v21
    v_dot2_f32_bf16 v22, v133, v13, v22
    v_dot2_f32_bf16 v23, v137, v13, v23
    v_dot2_f32_bf16 v24, v134, v13, v24
    v_dot2_f32_bf16 v25, v138, v13, v25
    v_dot2_f32_bf16 v26, v135, v13, v26
    v_dot2_f32_bf16 v27, v139, v13, v27
    v_mov_b32_dpp v12, v28 row_newbcast:12 row_mask:0xf bank_mask:0xf
    v_dot2_f32_bf16 v20, v140, v12, v20
    v_dot2_f32_bf16 v21, v144, v12, v21
    v_dot2_f32_bf16 v22, v141, v12, v22
    v_dot2_f32_bf16 v23, v145, v12, v23
    v_dot2_f32_bf16 v24, v142, v12, v24
    v_dot2_f32_bf16 v25, v146, v12, v25
    v_dot2_f32_bf16 v26, v143, v12, v26
    v_dot2_f32_bf16 v27, v147, v12, v27
    v_mov_b32_dpp v13, v28 row_newbcast:13 row_mask:0xf bank_mask:0xf
    v_dot2_f32_bf16 v20, v148, v13, v20
    v_dot2_f32_bf16 v21, v152, v13, v21
    v_dot2_f32_bf16 v22, v149, v13, v22
    v_dot2_f32_bf16 v23, v153, v13, v23
    v_dot2_f32_bf16 v24, v150, v13, v24
    v_dot2_f32_bf16 v25, v154, v13, v25
    v_dot2_f32_bf16 v26, v151, v13, v26
    v_dot2_f32_bf16 v27, v155, v13, v27
    v_mov_b32_dpp v12, v28 row_newbcast:14 row_mask:0xf bank_mask:0xf
    v_dot2_f32_bf16 v20, v156, v12, v20
    v_dot2_f32_bf16 v21, v160, v12, v21
    v_dot2_f32_bf16 v22, v157, v12, v22
    v_dot2_f32_bf16 v23, v161, v12, v23
    v_dot2_f32_bf16 v24, v158, v12, v24
    v_dot2_f32_bf16 v25, v162, v12, v25
    v_dot2_f32_bf16 v26, v159, v12, v26
    v_dot2_f32_bf16 v27, v163, v12, v27
    v_mov_b32_dpp v13, v28 row_newbcast:15 row_mask:0xf bank_mask:0xf
    v_dot2_f32_bf16 v20, v164, v13, v20
    v_dot2_f32_bf16 v21, v168, v13, v21
    v_dot2_f32_bf16 v22, v165, v13, v22
    v_dot2_f32_bf16 v23, v169, v13, v23
    v_dot2_f32_bf16 v24, v166, v13, v24
    v_dot2_f32_bf16 v25, v170, v13, v25
    v_dot2_f32_bf16 v26, v167, v13, v26
    v_dot2_f32_bf16 v27, v171, v13, v27
    v_permlane32_swap_b32 v20, v24
    v_permlane32_swap_b32 v21, v25
    v_permlane32_swap_b32 v22, v26
    v_permlane32_swap_b32 v23, v27
    v_add_f32 v20, v20, v24
    v_add_f32 v21, v21, v25
    v_add_f32 v22, v22, v26
    v_add_f32 v23, v23, v27
    s_nop 0
    v_permlane16_swap_b32 v20, v22
    v_permlane16_swap_b32 v21, v23
    v_add_f32 v20, v20, v22
    v_add_f32 v21, v21, v23
    v_max_u32 v20, 1, v20
    v_max_u32 v21, 1, v21
    buffer_store_dwordx2 v[20:21], v38, s[64:67], 0 offen sc1
    s_cmp_lg_u32 s71, 0
    s_cbranch_scc1 L_done
    v_max_u32 v14, 1, v8
    v_max_u32 v15, 1, v9
    s_mov_b64 exec, 1
    buffer_store_dwordx2 v[14:15], v37, s[64:67], 0 offen sc1
    s_mov_b64 exec, -1
    v_lshrrev_b32 v12, 2, v1
    v_and_b32 v13, 3, v1
    v_lshlrev_b32 v38, 11, v12
    v_lshl_add_u32 v38, v13, 4, v38
    v_lshlrev_b32 v37, 3, v12
    s_waitcnt vmcnt(2)
    v_readfirstlane_b32 s14, v41
    s_nop 0
    s_lshr_b32 s74, s14, 16
    s_cmp_lt_u32 s74, 96
    s_cbranch_scc1 L_done
    s_sub_u32 s77, s74, 96
    s_and_b32 s74, s14, 0xffff
    s_cmp_eq_u32 s74, 128
    s_cbranch_scc1 L_zok
    s_mov_b32 s11, 0x10000
L_zspin:
    s_sub_u32 s11, s11, 1
    s_cmp_eq_u32 s11, 0
    s_cbranch_scc1 L_zok
    s_mov_b64 exec, 1
    buffer_load_dword v41, v18, s[44:47], s76 offen sc1
    s_waitcnt vmcnt(0)
    v_readfirstlane_b32 s14, v41
    s_mov_b64 exec, -1
    s_and_b32 s74, s14, 0xffff
    s_cmp_eq_u32 s74, 128
    s_cbranch_scc0 L_zspin
L_zok:
    s_lshl_b32 s74, s70, 18
    s_lshl_b32 s75, s77, 6
    s_add_u32 s79, s74, s75
    s_lshl_b32 s74, s70, 10
    s_add_u32 s73, s74, 0x80000
    s_mov_b32 s11, 0x10000
L_poll:
    s_mov_b32 s72, s79
    buffer_load_dwordx2 v[76:77], v37, s[64:67], s73 offen offset:0 sc1
    buffer_load_dwordx2 v[78:79], v37, s[64:67], s73 offen offset:128 sc1
    buffer_load_dwordx2 v[80:81], v37, s[64:67], s73 offen offset:256 sc1
    buffer_load_dwordx2 v[82:83], v37, s[64:67], s73 offen offset:384 sc1
    buffer_load_dwordx2 v[84:85], v37, s[64:67], s73 offen offset:512 sc1
    buffer_load_dwordx2 v[86:87], v37, s[64:67], s73 offen offset:640 sc1
    buffer_load_dwordx2 v[88:89], v37, s[64:67], s73 offen offset:768 sc1
    buffer_load_dwordx2 v[90:91], v37, s[64:67], s73 offen offset:896 sc1
    buffer_load_dwordx4 v[44:47], v38, s[64:67], s72 offen sc1
    s_add_u32 s72, s72, 32768
    buffer_load_dwordx4 v[48:51], v38, s[64:67], s72 offen sc1
    s_add_u32 s72, s72, 32768
    buffer_load_dwordx4 v[52:55], v38, s[64:67], s72 offen sc1
    s_add_u32 s72, s72, 32768
    buffer_load_dwordx4 v[56:59], v38, s[64:67], s72 offen sc1
    s_add_u32 s72, s72, 32768
    buffer_load_dwordx4 v[60:63], v38, s[64:67], s72 offen sc1
    s_add_u32 s72, s72, 32768
    buffer_load_dwordx4 v[64:67], v38, s[64:67], s72 offen sc1
    s_add_u32 s72, s72, 32768
    buffer_load_dwordx4 v[68:71], v38, s[64:67], s72 offen sc1
    s_add_u32 s72, s72, 32768
    buffer_load_dwordx4 v[72:75], v38, s[64:67], s72 offen sc1
    s_waitcnt vmcnt(8)
    v_min3_u32 v12, v76, v77, v78
    v_min3_u32 v12, v12, v79, v80
    v_min3_u32 v12, v12, v81, v82
    v_min3_u32 v12, v12, v83, v84
    v_min3_u32 v12, v12, v85, v86
    v_min3_u32 v12, v12, v87, v88
    v_min3_u32 v12, v12, v89, v90
    v_min_u32 v12, v12, v91
    v_cmp_eq_u32 vcc, 0, v12
    s_sub_u32 s11, s11, 1
    s_cbranch_scc1 L_mlok
    s_cbranch_vccnz L_poll
L_mlok:
    v_max_f32_dpp v28, v76, v76 row_ror:4 row_mask:0xf bank_mask:0xf
    v_max_f32_dpp v29, v78, v78 row_ror:4 row_mask:0xf bank_mask:0xf
    v_max_f32_dpp v30, v80, v80 row_ror:4 row_mask:0xf bank_mask:0xf
    v_max_f32_dpp v31, v82, v82 row_ror:4 row_mask:0xf bank_mask:0xf
    v_max_f32_dpp v32, v84, v84 row_ror:4 row_mask:0xf bank_mask:0xf
    v_max_f32_dpp v33, v86, v86 row_ror:4 row_mask:0xf bank_mask:0xf
    v_max_f32_dpp v34, v88, v88 row_ror:4 row_mask:0xf bank_mask:0xf
    v_max_f32_dpp v35, v90, v90 row_ror:4 row_mask:0xf bank_mask:0xf
    v_max_f32_dpp v28, v28, v28 row_ror:8 row_mask:0xf bank_mask:0xf
    v_max_f32_dpp v29, v29, v29 row_ror:8 row_mask:0xf bank_mask:0xf
    v_max_f32_dpp v30, v30, v30 row_ror:8 row_mask:0xf bank_mask:0xf
    v_max_f32_dpp v31, v31, v31 row_ror:8 row_mask:0xf bank_mask:0xf
    v_max_f32_dpp v32, v32, v32 row_ror:8 row_mask:0xf bank_mask:0xf
    v_max_f32_dpp v33, v33, v33 row_ror:8 row_mask:0xf bank_mask:0xf
    v_max_f32_dpp v34, v34, v34 row_ror:8 row_mask:0xf bank_mask:0xf
    v_max_f32_dpp v35, v35, v35 row_ror:8 row_mask:0xf bank_mask:0xf
    v_sub_f32 v28, v76, v28
    v_sub_f32 v29, v78, v29
    v_sub_f32 v30, v80, v30
    v_sub_f32 v31, v82, v31
    v_sub_f32 v32, v84, v32
    v_sub_f32 v33, v86, v33
    v_sub_f32 v34, v88, v34
    v_sub_f32 v35, v90, v35
    v_exp_f32 v28, v28
    v_exp_f32 v29, v29
    v_exp_f32 v30, v30
    v_exp_f32 v31, v31
    v_exp_f32 v32, v32
    v_exp_f32 v33, v33
    v_exp_f32 v34, v34
    v_exp_f32 v35, v35
    v_mul_f32 v77, v77, v28
    v_mul_f32 v79, v79, v29
    v_mul_f32 v81, v81, v30
    v_mul_f32 v83, v83, v31
    v_mul_f32 v85, v85, v32
    v_mul_f32 v87, v87, v33
    v_mul_f32 v89, v89, v34
    v_mul_f32 v91, v91, v35
    v_add_f32_dpp v77, v77, v77 row_ror:4 row_mask:0xf bank_mask:0xf
    v_add_f32_dpp v79, v79, v79 row_ror:4 row_mask:0xf bank_mask:0xf
    v_add_f32_dpp v81, v81, v81 row_ror:4 row_mask:0xf bank_mask:0xf
    v_add_f32_dpp v83, v83, v83 row_ror:4 row_mask:0xf bank_mask:0xf
    v_add_f32_dpp v85, v85, v85 row_ror:4 row_mask:0xf bank_mask:0xf
    v_add_f32_dpp v87, v87, v87 row_ror:4 row_mask:0xf bank_mask:0xf
    v_add_f32_dpp v89, v89, v89 row_ror:4 row_mask:0xf bank_mask:0xf
    v_add_f32_dpp v91, v91, v91 row_ror:4 row_mask:0xf bank_mask:0xf
    v_add_f32_dpp v77, v77, v77 row_ror:8 row_mask:0xf bank_mask:0xf
    v_add_f32_dpp v79, v79, v79 row_ror:8 row_mask:0xf bank_mask:0xf
    v_add_f32_dpp v81, v81, v81 row_ror:8 row_mask:0xf bank_mask:0xf
    v_add_f32_dpp v83, v83, v83 row_ror:8 row_mask:0xf bank_mask:0xf
    v_add_f32_dpp v85, v85, v85 row_ror:8 row_mask:0xf bank_mask:0xf
    v_add_f32_dpp v87, v87, v87 row_ror:8 row_mask:0xf bank_mask:0xf
    v_add_f32_dpp v89, v89, v89 row_ror:8 row_mask:0xf bank_mask:0xf
    v_add_f32_dpp v91, v91, v91 row_ror:8 row_mask:0xf bank_mask:0xf
    v_rcp_f32 v77, v77
    v_rcp_f32 v79, v79
    v_rcp_f32 v81, v81
    v_rcp_f32 v83, v83
    v_rcp_f32 v85, v85
    v_rcp_f32 v87, v87
    v_rcp_f32 v89, v89
    v_rcp_f32 v91, v91
    v_mul_f32 v28, v28, v77
    v_mul_f32 v29, v29, v79
    v_mul_f32 v30, v30, v81
    v_mul_f32 v31, v31, v83
    v_mul_f32 v32, v32, v85
    v_mul_f32 v33, v33, v87
    v_mul_f32 v34, v34, v89
    v_mul_f32 v35, v35, v91
    s_waitcnt vmcnt(0)
    v_min3_u32 v12, v12, v44, v45
    v_min3_u32 v12, v12, v46, v47
    v_min3_u32 v12, v12, v48, v49
    v_min3_u32 v12, v12, v50, v51
    v_min3_u32 v12, v12, v52, v53
    v_min3_u32 v12, v12, v54, v55
    v_min3_u32 v12, v12, v56, v57
    v_min3_u32 v12, v12, v58, v59
    v_min3_u32 v12, v12, v60, v61
    v_min3_u32 v12, v12, v62, v63
    v_min3_u32 v12, v12, v64, v65
    v_min3_u32 v12, v12, v66, v67
    v_min3_u32 v12, v12, v68, v69
    v_min3_u32 v12, v12, v70, v71
    v_min3_u32 v12, v12, v72, v73
    v_min3_u32 v12, v12, v74, v75
    v_cmp_eq_u32 vcc, 0, v12
    s_sub_u32 s11, s11, 1
    s_cbranch_scc1 L_pollok
    s_cbranch_vccnz L_poll
L_pollok:
    v_mul_f32 v20, v28, v44
    v_mul_f32 v21, v28, v45
    v_mul_f32 v22, v28, v46
    v_mul_f32 v23, v28, v47
    v_fmac_f32 v20, v29, v48
    v_fmac_f32 v21, v29, v49
    v_fmac_f32 v22, v29, v50
    v_fmac_f32 v23, v29, v51
    v_fmac_f32 v20, v30, v52
    v_fmac_f32 v21, v30, v53
    v_fmac_f32 v22, v30, v54
    v_fmac_f32 v23, v30, v55
    v_fmac_f32 v20, v31, v56
    v_fmac_f32 v21, v31, v57
    v_fmac_f32 v22, v31, v58
    v_fmac_f32 v23, v31, v59
    v_fmac_f32 v20, v32, v60
    v_fmac_f32 v21, v32, v61
    v_fmac_f32 v22, v32, v62
    v_fmac_f32 v23, v32, v63
    v_fmac_f32 v20, v33, v64
    v_fmac_f32 v21, v33, v65
    v_fmac_f32 v22, v33, v66
    v_fmac_f32 v23, v33, v67
    v_fmac_f32 v20, v34, v68
    v_fmac_f32 v21, v34, v69
    v_fmac_f32 v22, v34, v70
    v_fmac_f32 v23, v34, v71
    v_fmac_f32 v20, v35, v72
    v_fmac_f32 v21, v35, v73
    v_fmac_f32 v22, v35, v74
    v_fmac_f32 v23, v35, v75
    v_add_f32_dpp v20, v20, v20 row_ror:4 row_mask:0xf bank_mask:0xf
    v_add_f32_dpp v21, v21, v21 row_ror:4 row_mask:0xf bank_mask:0xf
    v_add_f32_dpp v22, v22, v22 row_ror:4 row_mask:0xf bank_mask:0xf
    v_add_f32_dpp v23, v23, v23 row_ror:4 row_mask:0xf bank_mask:0xf
    v_add_f32_dpp v20, v20, v20 row_ror:8 row_mask:0xf bank_mask:0xf
    v_add_f32_dpp v21, v21, v21 row_ror:8 row_mask:0xf bank_mask:0xf
    v_add_f32_dpp v22, v22, v22 row_ror:8 row_mask:0xf bank_mask:0xf
    v_add_f32_dpp v23, v23, v23 row_ror:8 row_mask:0xf bank_mask:0xf
    s_nop 0
    v_permlane32_swap_b32 v20, v22
    v_permlane32_swap_b32 v21, v23
    v_add_f32 v20, v20, v22
    v_add_f32 v21, v21, v23
    s_nop 1
    v_permlane16_swap_b32 v20, v21
    v_add_f32 v20, v20, v21
    v_lshrrev_b32 v12, 4, v1
    v_and_b32 v13, 3, v1
    v_lshl_add_u32 v12, v13, 2, v12
    v_lshlrev_b32 v12, 1, v12
    v_cvt_pk_bf16_f32 v20, v20, v20
    s_lshl_b32 s74, s70, 10
    s_lshl_b32 s75, s77, 5
    s_add_u32 s74, s74, s75
    s_mov_b32 exec_lo, 0x000f000f
    s_mov_b32 exec_hi, 0x000f000f
    buffer_store_short v20, v12, s[48:51], s74 offen
L_done:
    s_endpgm
L_stream:
    s_lshl_b32 s74, s15, 12
    v_lshlrev_b32 v2, 4, v1
    v_add_u32 v2, s74, v2
    s_lshl_b32 s74, s68, 22
    s_lshl_b32 s75, s69, 20
    s_add_u32 s72, s74, s75
    s_waitcnt lgkmcnt(0)
    s_cmp_eq_u32 s70, 0
    s_cselect_b64 s[18:19], s[18:19], s[28:29]
    s_cselect_b64 s[20:21], s[20:21], s[30:31]
    s_add_u32 s44, s18, s72
    s_addc_u32 s45, s19, 0
    s_mov_b32 s46, 0x100000
    s_mov_b32 s47, 0x20000
    s_add_u32 s48, s20, s72
    s_addc_u32 s49, s21, 0
    s_mov_b32 s50, 0x100000
    s_mov_b32 s51, 0x20000
    s_mov_b32 s72, 0
    s_add_u32 s77, s72, 16384
    s_and_b32 s77, s77, 0xfffff
    buffer_load_dwordx4 v[108:111], v2, s[44:47], s72 offen offset:0 nt
    buffer_load_dwordx4 v[112:115], v2, s[44:47], s72 offen offset:1024 nt
    buffer_load_dwordx4 v[116:119], v2, s[44:47], s72 offen offset:2048 nt
    buffer_load_dwordx4 v[120:123], v2, s[44:47], s72 offen offset:3072 nt
    buffer_load_dwordx4 v[124:127], v2, s[48:51], s72 offen offset:0 nt
    buffer_load_dwordx4 v[128:131], v2, s[48:51], s72 offen offset:1024 nt
    buffer_load_dwordx4 v[132:135], v2, s[48:51], s72 offen offset:2048 nt
    buffer_load_dwordx4 v[136:139], v2, s[48:51], s72 offen offset:3072 nt
    s_barrier
    buffer_load_dwordx4 v[44:47], v2, s[44:47], s77 offen offset:0 nt
    buffer_load_dwordx4 v[48:51], v2, s[44:47], s77 offen offset:1024 nt
    buffer_load_dwordx4 v[52:55], v2, s[44:47], s77 offen offset:2048 nt
    buffer_load_dwordx4 v[56:59], v2, s[44:47], s77 offen offset:3072 nt
    buffer_load_dwordx4 v[60:63], v2, s[48:51], s77 offen offset:0 nt
    buffer_load_dwordx4 v[64:67], v2, s[48:51], s77 offen offset:1024 nt
    s_mov_b32 s76, 0x3e0293ee
    s_lshl_b32 s74, s15, 9
    s_add_u32 s74, s74, 2048
    v_lshlrev_b32 v36, 3, v1
    v_add_u32 v36, s74, v36
    s_lshl_b32 s74, s15, 3
    s_add_u32 s74, s74, 4096
    v_mov_b32 v37, s74
    v_lshlrev_b32 v13, 5, v13
    v_add_u32 v76, 0, v13
    s_mov_b32 s79, s77
    s_barrier
    v_mov_b32 v13, v76
    ds_read_b128 v[76:79], v13 offset:0
    ds_read_b128 v[80:83], v13 offset:16
    ds_read_b128 v[84:87], v13 offset:512
    ds_read_b128 v[88:91], v13 offset:528
    ds_read_b128 v[92:95], v13 offset:1024
    ds_read_b128 v[96:99], v13 offset:1040
    ds_read_b128 v[100:103], v13 offset:1536
    ds_read_b128 v[104:107], v13 offset:1552
    v_mov_b32 v20, 0
    v_mov_b32 v21, 0
    v_mov_b32 v22, 0
    v_mov_b32 v23, 0
    v_mov_b32 v24, 0
    v_mov_b32 v25, 0
    v_mov_b32 v26, 0
    v_mov_b32 v27, 0
    v_mov_b32 v10, 0xff800000
    v_mov_b32 v8, 0xff800000
    v_mov_b32 v9, 0
    s_mov_b32 s73, 63
    s_waitcnt lgkmcnt(0)
    v_pk_add_f32 v[76:77], v[76:77], v[84:85]
    v_pk_add_f32 v[92:93], v[92:93], v[100:101]
    v_pk_add_f32 v[78:79], v[78:79], v[86:87]
    v_pk_add_f32 v[94:95], v[94:95], v[102:103]
    v_pk_add_f32 v[80:81], v[80:81], v[88:89]
    v_pk_add_f32 v[96:97], v[96:97], v[104:105]
    v_pk_add_f32 v[82:83], v[82:83], v[90:91]
    v_pk_add_f32 v[98:99], v[98:99], v[106:107]
    v_pk_add_f32 v[76:77], v[76:77], v[92:93]
    v_pk_add_f32 v[78:79], v[78:79], v[94:95]
    v_pk_add_f32 v[80:81], v[80:81], v[96:97]
    v_pk_add_f32 v[82:83], v[82:83], v[98:99]
    v_cvt_pk_bf16_f32 v4, v76, v77
    v_cvt_pk_bf16_f32 v5, v78, v79
    v_cvt_pk_bf16_f32 v6, v80, v81
    v_cvt_pk_bf16_f32 v7, v82, v83
    s_waitcnt vmcnt(13)
    v_dot2_f32_bf16 v28, v108, v4, 0
    v_dot2_f32_bf16 v28, v109, v5, v28
    v_dot2_f32_bf16 v28, v110, v6, v28
    v_dot2_f32_bf16 v28, v111, v7, v28
    s_waitcnt vmcnt(12)
    v_dot2_f32_bf16 v29, v112, v4, 0
    v_dot2_f32_bf16 v29, v113, v5, v29
    v_dot2_f32_bf16 v29, v114, v6, v29
    v_dot2_f32_bf16 v29, v115, v7, v29
    s_waitcnt vmcnt(11)
    v_dot2_f32_bf16 v30, v116, v4, 0
    v_dot2_f32_bf16 v30, v117, v5, v30
    v_dot2_f32_bf16 v30, v118, v6, v30
    v_dot2_f32_bf16 v30, v119, v7, v30
    s_waitcnt vmcnt(10)
    v_dot2_f32_bf16 v31, v120, v4, 0
    v_dot2_f32_bf16 v31, v121, v5, v31
    v_dot2_f32_bf16 v31, v122, v6, v31
    v_dot2_f32_bf16 v31, v123, v7, v31
    v_add_f32_dpp v28, v28, v28 row_ror:8 row_mask:0xf bank_mask:0xf
    v_add_f32_dpp v29, v29, v29 row_ror:8 row_mask:0xf bank_mask:0xf
    v_add_f32_dpp v30, v30, v30 row_ror:8 row_mask:0xf bank_mask:0xf
    v_add_f32_dpp v31, v31, v31 row_ror:8 row_mask:0xf bank_mask:0xf
    v_add_f32_dpp v28, v28, v28 row_ror:4 row_mask:0xf bank_mask:0xf
    v_add_f32_dpp v29, v29, v29 row_ror:4 row_mask:0xf bank_mask:0xf
    v_add_f32_dpp v30, v30, v30 row_ror:4 row_mask:0xf bank_mask:0xf
    v_add_f32_dpp v31, v31, v31 row_ror:4 row_mask:0xf bank_mask:0xf
    v_add_f32_dpp v28, v28, v28 row_ror:2 row_mask:0xf bank_mask:0xf
    v_add_f32_dpp v29, v29, v29 row_ror:2 row_mask:0xf bank_mask:0xf
    v_add_f32_dpp v30, v30, v30 row_ror:2 row_mask:0xf bank_mask:0xf
    v_add_f32_dpp v31, v31, v31 row_ror:2 row_mask:0xf bank_mask:0xf
    v_add_f32_dpp v28, v28, v28 row_ror:1 row_mask:0xf bank_mask:0xf
    v_add_f32_dpp v29, v29, v29 row_ror:1 row_mask:0xf bank_mask:0xf
    v_add_f32_dpp v30, v30, v30 row_ror:1 row_mask:0xf bank_mask:0xf
    v_add_f32_dpp v31, v31, v31 row_ror:1 row_mask:0xf bank_mask:0xf
    v_max3_f32 v8, v8, v28, v29
    v_max3_f32 v8, v8, v30, v31
    v_mul_f32 v12, s76, v8
    v_sub_f32 v11, v10, v12
    v_mov_b32 v10, v12
    v_exp_f32 v11, v11
    v_fma_f32 v28, v28, s76, -v10
    v_fma_f32 v29, v29, s76, -v10
    v_fma_f32 v30, v30, s76, -v10
    v_fma_f32 v31, v31, s76, -v10
    v_exp_f32 v28, v28
    v_exp_f32 v29, v29
    v_exp_f32 v30, v30
    v_exp_f32 v31, v31
    v_mul_f32 v9, v9, v11
    v_pk_mul_f32 v[20:21], v[20:21], v[10:11] op_sel:[0,1] op_sel_hi:[1,1]
    v_pk_mul_f32 v[22:23], v[22:23], v[10:11] op_sel:[0,1] op_sel_hi:[1,1]
    v_pk_mul_f32 v[24:25], v[24:25], v[10:11] op_sel:[0,1] op_sel_hi:[1,1]
    v_pk_mul_f32 v[26:27], v[26:27], v[10:11] op_sel:[0,1] op_sel_hi:[1,1]
    v_add_f32 v9, v9, v28
    v_add_f32 v9, v9, v29
    v_add_f32 v9, v9, v30
    v_add_f32 v9, v9, v31
    s_waitcnt vmcnt(9)
    v_lshlrev_b32 v12, 16, v124
    v_and_b32 v13, 0xffff0000, v124
    v_lshlrev_b32 v14, 16, v125
    v_and_b32 v15, 0xffff0000, v125
    v_lshlrev_b32 v16, 16, v126
    v_and_b32 v17, 0xffff0000, v126
    v_lshlrev_b32 v18, 16, v127
    v_and_b32 v19, 0xffff0000, v127
    v_pk_fma_f32 v[20:21], v[12:13], v[28:29], v[20:21] op_sel:[0,0,0] op_sel_hi:[1,0,1]
    v_pk_fma_f32 v[22:23], v[14:15], v[28:29], v[22:23] op_sel:[0,0,0] op_sel_hi:[1,0,1]
    v_pk_fma_f32 v[24:25], v[16:17], v[28:29], v[24:25] op_sel:[0,0,0] op_sel_hi:[1,0,1]
    v_pk_fma_f32 v[26:27], v[18:19], v[28:29], v[26:27] op_sel:[0,0,0] op_sel_hi:[1,0,1]
    s_waitcnt vmcnt(8)
    v_lshlrev_b32 v12, 16, v128
    v_and_b32 v13, 0xffff0000, v128
    v_lshlrev_b32 v14, 16, v129
    v_and_b32 v15, 0xffff0000, v129
    v_lshlrev_b32 v16, 16, v130
    v_and_b32 v17, 0xffff0000, v130
    v_lshlrev_b32 v18, 16, v131
    v_and_b32 v19, 0xffff0000, v131
    v_pk_fma_f32 v[20:21], v[12:13], v[28:29], v[20:21] op_sel:[0,1,0] op_sel_hi:[1,1,1]
    v_pk_fma_f32 v[22:23], v[14:15], v[28:29], v[22:23] op_sel:[0,1,0] op_sel_hi:[1,1,1]
    v_pk_fma_f32 v[24:25], v[16:17], v[28:29], v[24:25] op_sel:[0,1,0] op_sel_hi:[1,1,1]
    v_pk_fma_f32 v[26:27], v[18:19], v[28:29], v[26:27] op_sel:[0,1,0] op_sel_hi:[1,1,1]
    s_waitcnt vmcnt(7)
    v_lshlrev_b32 v12, 16, v132
    v_and_b32 v13, 0xffff0000, v132
    v_lshlrev_b32 v14, 16, v133
    v_and_b32 v15, 0xffff0000, v133
    v_lshlrev_b32 v16, 16, v134
    v_and_b32 v17, 0xffff0000, v134
    v_lshlrev_b32 v18, 16, v135
    v_and_b32 v19, 0xffff0000, v135
    v_pk_fma_f32 v[20:21], v[12:13], v[30:31], v[20:21] op_sel:[0,0,0] op_sel_hi:[1,0,1]
    v_pk_fma_f32 v[22:23], v[14:15], v[30:31], v[22:23] op_sel:[0,0,0] op_sel_hi:[1,0,1]
    v_pk_fma_f32 v[24:25], v[16:17], v[30:31], v[24:25] op_sel:[0,0,0] op_sel_hi:[1,0,1]
    v_pk_fma_f32 v[26:27], v[18:19], v[30:31], v[26:27] op_sel:[0,0,0] op_sel_hi:[1,0,1]
    s_waitcnt vmcnt(6)
    v_lshlrev_b32 v12, 16, v136
    v_and_b32 v13, 0xffff0000, v136
    v_lshlrev_b32 v14, 16, v137
    v_and_b32 v15, 0xffff0000, v137
    v_lshlrev_b32 v16, 16, v138
    v_and_b32 v17, 0xffff0000, v138
    v_lshlrev_b32 v18, 16, v139
    v_and_b32 v19, 0xffff0000, v139
    v_pk_fma_f32 v[20:21], v[12:13], v[30:31], v[20:21] op_sel:[0,1,0] op_sel_hi:[1,1,1]
    v_pk_fma_f32 v[22:23], v[14:15], v[30:31], v[22:23] op_sel:[0,1,0] op_sel_hi:[1,1,1]
    v_pk_fma_f32 v[24:25], v[16:17], v[30:31], v[24:25] op_sel:[0,1,0] op_sel_hi:[1,1,1]
    v_pk_fma_f32 v[26:27], v[18:19], v[30:31], v[26:27] op_sel:[0,1,0] op_sel_hi:[1,1,1]
    s_mov_b32 s72, s77
    s_add_u32 s79, s77, 16384
    s_and_b32 s79, s79, 0xfffff
    s_mov_b32 s77, s79
.p2align 6
L_loop:
    s_waitcnt vmcnt(5)
    v_dot2_f32_bf16 v28, v44, v4, 0
    v_dot2_f32_bf16 v28, v45, v5, v28
    v_dot2_f32_bf16 v28, v46, v6, v28
    v_dot2_f32_bf16 v28, v47, v7, v28
    buffer_load_dwordx4 v[68:71], v2, s[48:51], s72 offen offset:2048 nt
    s_waitcnt vmcnt(5)
    v_dot2_f32_bf16 v29, v48, v4, 0
    v_dot2_f32_bf16 v29, v49, v5, v29
    v_dot2_f32_bf16 v29, v50, v6, v29
    v_dot2_f32_bf16 v29, v51, v7, v29
    buffer_load_dwordx4 v[72:75], v2, s[48:51], s72 offen offset:3072 nt
    s_waitcnt vmcnt(5)
    v_dot2_f32_bf16 v30, v52, v4, 0
    v_dot2_f32_bf16 v30, v53, v5, v30
    v_dot2_f32_bf16 v30, v54, v6, v30
    v_dot2_f32_bf16 v30, v55, v7, v30
    buffer_load_dwordx4 v[44:47], v2, s[44:47], s77 offen offset:0 nt
    s_waitcnt vmcnt(5)
    v_dot2_f32_bf16 v31, v56, v4, 0
    v_dot2_f32_bf16 v31, v57, v5, v31
    v_dot2_f32_bf16 v31, v58, v6, v31
    v_dot2_f32_bf16 v31, v59, v7, v31
    buffer_load_dwordx4 v[48:51], v2, s[44:47], s77 offen offset:1024 nt
    v_add_f32_dpp v28, v28, v28 row_ror:8 row_mask:0xf bank_mask:0xf
    v_add_f32_dpp v29, v29, v29 row_ror:8 row_mask:0xf bank_mask:0xf
    v_add_f32_dpp v30, v30, v30 row_ror:8 row_mask:0xf bank_mask:0xf
    v_add_f32_dpp v31, v31, v31 row_ror:8 row_mask:0xf bank_mask:0xf
    v_add_f32_dpp v28, v28, v28 row_ror:4 row_mask:0xf bank_mask:0xf
    v_add_f32_dpp v29, v29, v29 row_ror:4 row_mask:0xf bank_mask:0xf
    v_add_f32_dpp v30, v30, v30 row_ror:4 row_mask:0xf bank_mask:0xf
    v_add_f32_dpp v31, v31, v31 row_ror:4 row_mask:0xf bank_mask:0xf
    v_add_f32_dpp v28, v28, v28 row_ror:2 row_mask:0xf bank_mask:0xf
    v_add_f32_dpp v29, v29, v29 row_ror:2 row_mask:0xf bank_mask:0xf
    v_add_f32_dpp v30, v30, v30 row_ror:2 row_mask:0xf bank_mask:0xf
    v_add_f32_dpp v31, v31, v31 row_ror:2 row_mask:0xf bank_mask:0xf
    v_add_f32_dpp v28, v28, v28 row_ror:1 row_mask:0xf bank_mask:0xf
    v_add_f32_dpp v29, v29, v29 row_ror:1 row_mask:0xf bank_mask:0xf
    v_add_f32_dpp v30, v30, v30 row_ror:1 row_mask:0xf bank_mask:0xf
    v_add_f32_dpp v31, v31, v31 row_ror:1 row_mask:0xf bank_mask:0xf
    v_max3_f32 v8, v8, v28, v29
    v_max3_f32 v8, v8, v30, v31
    v_mul_f32 v12, s76, v8
    v_sub_f32 v11, v10, v12
    v_mov_b32 v10, v12
    v_exp_f32 v11, v11
    v_fma_f32 v28, v28, s76, -v10
    v_fma_f32 v29, v29, s76, -v10
    v_fma_f32 v30, v30, s76, -v10
    v_fma_f32 v31, v31, s76, -v10
    v_exp_f32 v28, v28
    v_exp_f32 v29, v29
    v_exp_f32 v30, v30
    v_exp_f32 v31, v31
    v_mul_f32 v9, v9, v11
    v_pk_mul_f32 v[20:21], v[20:21], v[10:11] op_sel:[0,1] op_sel_hi:[1,1]
    v_pk_mul_f32 v[22:23], v[22:23], v[10:11] op_sel:[0,1] op_sel_hi:[1,1]
    v_pk_mul_f32 v[24:25], v[24:25], v[10:11] op_sel:[0,1] op_sel_hi:[1,1]
    v_pk_mul_f32 v[26:27], v[26:27], v[10:11] op_sel:[0,1] op_sel_hi:[1,1]
    v_add_f32 v9, v9, v28
    v_add_f32 v9, v9, v29
    v_add_f32 v9, v9, v30
    v_add_f32 v9, v9, v31
    s_waitcnt vmcnt(5)
    v_lshlrev_b32 v12, 16, v60
    v_and_b32 v13, 0xffff0000, v60
    v_lshlrev_b32 v14, 16, v61
    v_and_b32 v15, 0xffff0000, v61
    v_lshlrev_b32 v16, 16, v62
    v_and_b32 v17, 0xffff0000, v62
    v_lshlrev_b32 v18, 16, v63
    v_and_b32 v19, 0xffff0000, v63
    v_pk_fma_f32 v[20:21], v[12:13], v[28:29], v[20:21] op_sel:[0,0,0] op_sel_hi:[1,0,1]
    v_pk_fma_f32 v[22:23], v[14:15], v[28:29], v[22:23] op_sel:[0,0,0] op_sel_hi:[1,0,1]
    v_pk_fma_f32 v[24:25], v[16:17], v[28:29], v[24:25] op_sel:[0,0,0] op_sel_hi:[1,0,1]
    v_pk_fma_f32 v[26:27], v[18:19], v[28:29], v[26:27] op_sel:[0,0,0] op_sel_hi:[1,0,1]
    buffer_load_dwordx4 v[52:55], v2, s[44:47], s77 offen offset:2048 nt
    s_waitcnt vmcnt(5)
    v_lshlrev_b32 v12, 16, v64
    v_and_b32 v13, 0xffff0000, v64
    v_lshlrev_b32 v14, 16, v65
    v_and_b32 v15, 0xffff0000, v65
    v_lshlrev_b32 v16, 16, v66
    v_and_b32 v17, 0xffff0000, v66
    v_lshlrev_b32 v18, 16, v67
    v_and_b32 v19, 0xffff0000, v67
    v_pk_fma_f32 v[20:21], v[12:13], v[28:29], v[20:21] op_sel:[0,1,0] op_sel_hi:[1,1,1]
    v_pk_fma_f32 v[22:23], v[14:15], v[28:29], v[22:23] op_sel:[0,1,0] op_sel_hi:[1,1,1]
    v_pk_fma_f32 v[24:25], v[16:17], v[28:29], v[24:25] op_sel:[0,1,0] op_sel_hi:[1,1,1]
    v_pk_fma_f32 v[26:27], v[18:19], v[28:29], v[26:27] op_sel:[0,1,0] op_sel_hi:[1,1,1]
    buffer_load_dwordx4 v[56:59], v2, s[44:47], s77 offen offset:3072 nt
    s_waitcnt vmcnt(5)
    v_lshlrev_b32 v12, 16, v68
    v_and_b32 v13, 0xffff0000, v68
    v_lshlrev_b32 v14, 16, v69
    v_and_b32 v15, 0xffff0000, v69
    v_lshlrev_b32 v16, 16, v70
    v_and_b32 v17, 0xffff0000, v70
    v_lshlrev_b32 v18, 16, v71
    v_and_b32 v19, 0xffff0000, v71
    v_pk_fma_f32 v[20:21], v[12:13], v[30:31], v[20:21] op_sel:[0,0,0] op_sel_hi:[1,0,1]
    v_pk_fma_f32 v[22:23], v[14:15], v[30:31], v[22:23] op_sel:[0,0,0] op_sel_hi:[1,0,1]
    v_pk_fma_f32 v[24:25], v[16:17], v[30:31], v[24:25] op_sel:[0,0,0] op_sel_hi:[1,0,1]
    v_pk_fma_f32 v[26:27], v[18:19], v[30:31], v[26:27] op_sel:[0,0,0] op_sel_hi:[1,0,1]
    buffer_load_dwordx4 v[60:63], v2, s[48:51], s77 offen offset:0 nt
    s_waitcnt vmcnt(5)
    v_lshlrev_b32 v12, 16, v72
    v_and_b32 v13, 0xffff0000, v72
    v_lshlrev_b32 v14, 16, v73
    v_and_b32 v15, 0xffff0000, v73
    v_lshlrev_b32 v16, 16, v74
    v_and_b32 v17, 0xffff0000, v74
    v_lshlrev_b32 v18, 16, v75
    v_and_b32 v19, 0xffff0000, v75
    v_pk_fma_f32 v[20:21], v[12:13], v[30:31], v[20:21] op_sel:[0,1,0] op_sel_hi:[1,1,1]
    v_pk_fma_f32 v[22:23], v[14:15], v[30:31], v[22:23] op_sel:[0,1,0] op_sel_hi:[1,1,1]
    v_pk_fma_f32 v[24:25], v[16:17], v[30:31], v[24:25] op_sel:[0,1,0] op_sel_hi:[1,1,1]
    v_pk_fma_f32 v[26:27], v[18:19], v[30:31], v[26:27] op_sel:[0,1,0] op_sel_hi:[1,1,1]
    buffer_load_dwordx4 v[64:67], v2, s[48:51], s77 offen offset:1024 nt
    s_mov_b32 s72, s79
    s_add_u32 s79, s79, 16384
    s_and_b32 s79, s79, 0xfffff
    s_sub_u32 s73, s73, 1
    s_cmp_eq_u32 s73, 1
    s_cselect_b32 s77, 0x100000, s79
    s_cmp_lg_u32 s73, 0
    s_cbranch_scc1 L_loop
    v_mov_b32 v12, v10
    v_mov_b32 v13, v10
    s_nop 1
    v_permlane32_swap_b32 v12, v13
    v_max_f32 v12, v12, v13
    v_mov_b32 v13, v12
    s_nop 1
    v_permlane16_swap_b32 v12, v13
    v_max_f32 v14, v12, v13
    v_sub_f32 v11, v10, v14
    v_exp_f32 v11, v11
    s_nop 0
    v_mul_f32 v9, v9, v11
    v_pk_mul_f32 v[20:21], v[20:21], v[10:11] op_sel:[0,1] op_sel_hi:[1,1]
    v_pk_mul_f32 v[22:23], v[22:23], v[10:11] op_sel:[0,1] op_sel_hi:[1,1]
    v_pk_mul_f32 v[24:25], v[24:25], v[10:11] op_sel:[0,1] op_sel_hi:[1,1]
    v_pk_mul_f32 v[26:27], v[26:27], v[10:11] op_sel:[0,1] op_sel_hi:[1,1]
    v_mov_b32 v13, v9
    s_nop 1
    v_permlane32_swap_b32 v9, v13
    v_add_f32 v9, v9, v13
    v_mov_b32 v13, v9
    v_permlane32_swap_b32 v20, v24
    v_permlane32_swap_b32 v21, v25
    v_permlane32_swap_b32 v22, v26
    v_permlane32_swap_b32 v23, v27
    v_add_f32 v20, v20, v24
    v_add_f32 v21, v21, v25
    v_add_f32 v22, v22, v26
    v_add_f32 v23, v23, v27
    s_nop 0
    v_permlane16_swap_b32 v20, v22
    v_permlane16_swap_b32 v21, v23
    v_add_f32 v20, v20, v22
    v_add_f32 v21, v21, v23
    v_permlane16_swap_b32 v9, v13
    v_add_f32 v15, v9, v13
    ds_write_b64 v36, v[20:21]
    s_mov_b64 exec, 1
    ds_write_b64 v37, v[14:15]
    s_waitcnt lgkmcnt(0)
    s_barrier
L_end:
    s_endpgm
L_code_end:
.section .rodata,"a"
.p2align 6
.amdhsa_kernel concat_heads__mha_block_cached__mha_block_cached__decode_kernel
  .amdhsa_next_free_vgpr 172
  .amdhsa_next_free_sgpr 96
  .amdhsa_accum_offset 172
  .amdhsa_group_segment_fixed_size 0
  .amdhsa_kernarg_size 104
  .amdhsa_user_sgpr_count 2
  .amdhsa_user_sgpr_kernarg_segment_ptr 1
  .amdhsa_system_sgpr_workgroup_id_x 1
  .amdhsa_float_denorm_mode_32 3
.end_amdhsa_kernel
```
